```python
import torch

def _softmax(x, axis=-1):
    return torch.softmax(x, dim=axis)
def _gelu(x):
    return torch.nn.functional.gelu(x, approximate="tanh")
def _silu(x):
    return torch.nn.functional.silu(x)
def _sigmoid(x):
    return torch.sigmoid(x)
def _layernorm(x, axis=-1, eps=1e-5):
    m = x.mean(dim=axis, keepdim=True)
    v = x.var(dim=axis, keepdim=True, unbiased=False)
    return (x - m) / torch.sqrt(v + eps)
def _scatter_add(tgt, idx, src, axis=0):
    return tgt.clone().index_add_(axis, idx, src)
def _segment_sum(src, seg, n):
    out = torch.zeros((n,) + src.shape[1:], dtype=src.dtype)
    return out.index_add_(0, seg, src)
def _pad(x, pw):
    flat = tuple(v for pair in reversed(pw) for v in pair)
    return torch.nn.functional.pad(x, flat)

kernel_name = 'standalone__consistency_rf_step__diffusion'

def setup_inputs():

    _w = (lambda a: (lambda t: t.to(torch.bfloat16) if t.is_floating_point() else t)(torch.as_tensor(a)))
    B, C, HW = 2, 320, 128
    return {
        "x": _w((lambda *s: torch.randn(*s, dtype=torch.bfloat16) * 0.05)(B, C, HW, HW)),
        "v": _w((lambda *s: torch.randn(*s, dtype=torch.bfloat16) * 0.05)(B, C, HW, HW)),
        "sigma": _w(torch.rand(B).to(float)),
    }

def reference(x, v, sigma):
    s = sigma.reshape(-1, 1, 1, 1)
    return x - s * v
```

```asm
; @launch grid=(1280,1,1) block=(256,1,1) lds=0
.amdgcn_target "amdgcn-amd-amdhsa--gfx950"
.text
.globl standalone__consistency_rf_step__diffusion_kernel
.p2align 8
.type standalone__consistency_rf_step__diffusion_kernel,@function
standalone__consistency_rf_step__diffusion_kernel:
    s_load_dwordx8 s[4:11], s[0:1], 0
    s_lshl_b32 s3, s2, 14
    s_cmpk_ge_u32 s2, 1280
    s_cbranch_scc1 L_end
    s_bitset1_b32 s3, 12
    v_lshl_add_u32 v1, v0, 4, s3
    v_add_u32 v2, 0x2000, v1
    s_waitcnt lgkmcnt(0)
    s_load_dword s14, s[8:9], 0
    global_load_dwordx4 v[8:11], v1, s[6:7] offset:-4096 nt
    global_load_dwordx4 v[4:7], v1, s[4:5] offset:-4096 nt
    global_load_dwordx4 v[16:19], v1, s[6:7] nt
    global_load_dwordx4 v[12:15], v1, s[4:5] nt
    global_load_dwordx4 v[24:27], v2, s[6:7] offset:-4096 nt
    global_load_dwordx4 v[20:23], v2, s[4:5] offset:-4096 nt
    s_bitcmp1_b32 s2, 0
    s_cselect_b32 s12, 224, -1
    s_cselect_b32 s13, 0, 32
    v_cmp_gt_u32 s[24:25], s12, v0
    v_subrev_u32 v3, 192, v0
    v_cmp_gt_u32 s[22:23], s13, v3
    v_add_u32 v3, 25088, v1
    s_mov_b64 exec, s[24:25]
    global_load_dwordx4 v[32:35], v2, s[6:7] nt
    global_load_dwordx4 v[28:31], v2, s[4:5] nt
    s_mov_b64 exec, s[22:23]
    s_cbranch_execz L_noE
    global_load_dwordx4 v[48:51], v3, s[6:7] nt
    global_load_dwordx4 v[44:47], v3, s[4:5] nt
L_noE:
    s_mov_b64 exec, -1
    s_mov_b32 s16, 0xffff0000
    s_sub_u32 s20, s2, 320
    s_waitcnt lgkmcnt(0)
    s_lshl_b32 s15, s14, 16
    s_and_b32 s14, s14, s16
    s_cmpk_ge_u32 s2, 640
    s_cselect_b32 s18, s14, s15
    s_mov_b32 s19, s18
    s_cmpk_lt_u32 s20, 704
    s_waitcnt vmcnt(7)
    v_lshlrev_b32 v36, 16, v8
    v_and_b32 v37, s16, v8
    v_lshlrev_b32 v38, 16, v9
    v_and_b32 v39, s16, v9
    v_lshlrev_b32 v40, 16, v10
    v_and_b32 v41, s16, v10
    v_lshlrev_b32 v42, 16, v11
    v_and_b32 v43, s16, v11
    v_pk_mul_f32 v[36:37], v[36:37], s[18:19]
    v_pk_mul_f32 v[38:39], v[38:39], s[18:19]
    v_pk_mul_f32 v[40:41], v[40:41], s[18:19]
    v_pk_mul_f32 v[42:43], v[42:43], s[18:19]
    v_cvt_pk_bf16_f32 v8, v36, v37
    v_cvt_pk_bf16_f32 v9, v38, v39
    v_cvt_pk_bf16_f32 v10, v40, v41
    v_cvt_pk_bf16_f32 v11, v42, v43
    v_lshlrev_b32 v36, 16, v8
    v_and_b32 v37, s16, v8
    v_lshlrev_b32 v38, 16, v9
    v_and_b32 v39, s16, v9
    v_lshlrev_b32 v40, 16, v10
    v_and_b32 v41, s16, v10
    v_lshlrev_b32 v42, 16, v11
    v_and_b32 v43, s16, v11
    s_waitcnt vmcnt(6)
    v_lshlrev_b32 v8, 16, v4
    v_and_b32 v9, s16, v4
    v_lshlrev_b32 v10, 16, v5
    v_and_b32 v11, s16, v5
    v_pk_add_f32 v[36:37], v[8:9], v[36:37] neg_lo:[0,1] neg_hi:[0,1]
    v_pk_add_f32 v[38:39], v[10:11], v[38:39] neg_lo:[0,1] neg_hi:[0,1]
    v_lshlrev_b32 v8, 16, v6
    v_and_b32 v9, s16, v6
    v_lshlrev_b32 v10, 16, v7
    v_and_b32 v11, s16, v7
    v_pk_add_f32 v[40:41], v[8:9], v[40:41] neg_lo:[0,1] neg_hi:[0,1]
    v_pk_add_f32 v[42:43], v[10:11], v[42:43] neg_lo:[0,1] neg_hi:[0,1]
    v_cvt_pk_bf16_f32 v4, v36, v37
    v_cvt_pk_bf16_f32 v5, v38, v39
    v_cvt_pk_bf16_f32 v6, v40, v41
    v_cvt_pk_bf16_f32 v7, v42, v43
    s_cbranch_scc1 L_sB0
    global_store_dwordx4 v1, v[4:7], s[10:11] offset:-4096
    s_branch L_sC0
L_sB0:
    global_store_dwordx4 v1, v[4:7], s[10:11] offset:-4096 sc0 sc1
L_sC0:
    s_waitcnt vmcnt(6)
    v_lshlrev_b32 v36, 16, v16
    v_and_b32 v37, s16, v16
    v_lshlrev_b32 v38, 16, v17
    v_and_b32 v39, s16, v17
    v_lshlrev_b32 v40, 16, v18
    v_and_b32 v41, s16, v18
    v_lshlrev_b32 v42, 16, v19
    v_and_b32 v43, s16, v19
    v_pk_mul_f32 v[36:37], v[36:37], s[18:19]
    v_pk_mul_f32 v[38:39], v[38:39], s[18:19]
    v_pk_mul_f32 v[40:41], v[40:41], s[18:19]
    v_pk_mul_f32 v[42:43], v[42:43], s[18:19]
    v_cvt_pk_bf16_f32 v16, v36, v37
    v_cvt_pk_bf16_f32 v17, v38, v39
    v_cvt_pk_bf16_f32 v18, v40, v41
    v_cvt_pk_bf16_f32 v19, v42, v43
    v_lshlrev_b32 v36, 16, v16
    v_and_b32 v37, s16, v16
    v_lshlrev_b32 v38, 16, v17
    v_and_b32 v39, s16, v17
    v_lshlrev_b32 v40, 16, v18
    v_and_b32 v41, s16, v18
    v_lshlrev_b32 v42, 16, v19
    v_and_b32 v43, s16, v19
    s_waitcnt vmcnt(5)
    v_lshlrev_b32 v16, 16, v12
    v_and_b32 v17, s16, v12
    v_lshlrev_b32 v18, 16, v13
    v_and_b32 v19, s16, v13
    v_pk_add_f32 v[36:37], v[16:17], v[36:37] neg_lo:[0,1] neg_hi:[0,1]
    v_pk_add_f32 v[38:39], v[18:19], v[38:39] neg_lo:[0,1] neg_hi:[0,1]
    v_lshlrev_b32 v16, 16, v14
    v_and_b32 v17, s16, v14
    v_lshlrev_b32 v18, 16, v15
    v_and_b32 v19, s16, v15
    v_pk_add_f32 v[40:41], v[16:17], v[40:41] neg_lo:[0,1] neg_hi:[0,1]
    v_pk_add_f32 v[42:43], v[18:19], v[42:43] neg_lo:[0,1] neg_hi:[0,1]
    v_cvt_pk_bf16_f32 v12, v36, v37
    v_cvt_pk_bf16_f32 v13, v38, v39
    v_cvt_pk_bf16_f32 v14, v40, v41
    v_cvt_pk_bf16_f32 v15, v42, v43
    s_cbranch_scc1 L_sB1
    global_store_dwordx4 v1, v[12:15], s[10:11]
    s_branch L_sC1
L_sB1:
    global_store_dwordx4 v1, v[12:15], s[10:11] sc0 sc1
L_sC1:
    s_waitcnt vmcnt(5)
    v_lshlrev_b32 v36, 16, v24
    v_and_b32 v37, s16, v24
    v_lshlrev_b32 v38, 16, v25
    v_and_b32 v39, s16, v25
    v_lshlrev_b32 v40, 16, v26
    v_and_b32 v41, s16, v26
    v_lshlrev_b32 v42, 16, v27
    v_and_b32 v43, s16, v27
    v_pk_mul_f32 v[36:37], v[36:37], s[18:19]
    v_pk_mul_f32 v[38:39], v[38:39], s[18:19]
    v_pk_mul_f32 v[40:41], v[40:41], s[18:19]
    v_pk_mul_f32 v[42:43], v[42:43], s[18:19]
    v_cvt_pk_bf16_f32 v24, v36, v37
    v_cvt_pk_bf16_f32 v25, v38, v39
    v_cvt_pk_bf16_f32 v26, v40, v41
    v_cvt_pk_bf16_f32 v27, v42, v43
    v_lshlrev_b32 v36, 16, v24
    v_and_b32 v37, s16, v24
    v_lshlrev_b32 v38, 16, v25
    v_and_b32 v39, s16, v25
    v_lshlrev_b32 v40, 16, v26
    v_and_b32 v41, s16, v26
    v_lshlrev_b32 v42, 16, v27
    v_and_b32 v43, s16, v27
    s_waitcnt vmcnt(4)
    v_lshlrev_b32 v24, 16, v20
    v_and_b32 v25, s16, v20
    v_lshlrev_b32 v26, 16, v21
    v_and_b32 v27, s16, v21
    v_pk_add_f32 v[36:37], v[24:25], v[36:37] neg_lo:[0,1] neg_hi:[0,1]
    v_pk_add_f32 v[38:39], v[26:27], v[38:39] neg_lo:[0,1] neg_hi:[0,1]
    v_lshlrev_b32 v24, 16, v22
    v_and_b32 v25, s16, v22
    v_lshlrev_b32 v26, 16, v23
    v_and_b32 v27, s16, v23
    v_pk_add_f32 v[40:41], v[24:25], v[40:41] neg_lo:[0,1] neg_hi:[0,1]
    v_pk_add_f32 v[42:43], v[26:27], v[42:43] neg_lo:[0,1] neg_hi:[0,1]
    v_cvt_pk_bf16_f32 v20, v36, v37
    v_cvt_pk_bf16_f32 v21, v38, v39
    v_cvt_pk_bf16_f32 v22, v40, v41
    v_cvt_pk_bf16_f32 v23, v42, v43
    s_cbranch_scc1 L_sB2
    global_store_dwordx4 v2, v[20:23], s[10:11] offset:-4096
    s_branch L_sC2
L_sB2:
    global_store_dwordx4 v2, v[20:23], s[10:11] offset:-4096 sc0 sc1
L_sC2:
    s_waitcnt vmcnt(4)
    v_lshlrev_b32 v36, 16, v32
    v_and_b32 v37, s16, v32
    v_lshlrev_b32 v38, 16, v33
    v_and_b32 v39, s16, v33
    v_lshlrev_b32 v40, 16, v34
    v_and_b32 v41, s16, v34
    v_lshlrev_b32 v42, 16, v35
    v_and_b32 v43, s16, v35
    v_pk_mul_f32 v[36:37], v[36:37], s[18:19]
    v_pk_mul_f32 v[38:39], v[38:39], s[18:19]
    v_pk_mul_f32 v[40:41], v[40:41], s[18:19]
    v_pk_mul_f32 v[42:43], v[42:43], s[18:19]
    v_cvt_pk_bf16_f32 v32, v36, v37
    v_cvt_pk_bf16_f32 v33, v38, v39
    v_cvt_pk_bf16_f32 v34, v40, v41
    v_cvt_pk_bf16_f32 v35, v42, v43
    v_lshlrev_b32 v36, 16, v32
    v_and_b32 v37, s16, v32
    v_lshlrev_b32 v38, 16, v33
    v_and_b32 v39, s16, v33
    v_lshlrev_b32 v40, 16, v34
    v_and_b32 v41, s16, v34
    v_lshlrev_b32 v42, 16, v35
    v_and_b32 v43, s16, v35
    s_waitcnt vmcnt(3)
    v_lshlrev_b32 v32, 16, v28
    v_and_b32 v33, s16, v28
    v_lshlrev_b32 v34, 16, v29
    v_and_b32 v35, s16, v29
    v_pk_add_f32 v[36:37], v[32:33], v[36:37] neg_lo:[0,1] neg_hi:[0,1]
    v_pk_add_f32 v[38:39], v[34:35], v[38:39] neg_lo:[0,1] neg_hi:[0,1]
    v_lshlrev_b32 v32, 16, v30
    v_and_b32 v33, s16, v30
    v_lshlrev_b32 v34, 16, v31
    v_and_b32 v35, s16, v31
    v_pk_add_f32 v[40:41], v[32:33], v[40:41] neg_lo:[0,1] neg_hi:[0,1]
    v_pk_add_f32 v[42:43], v[34:35], v[42:43] neg_lo:[0,1] neg_hi:[0,1]
    v_cvt_pk_bf16_f32 v28, v36, v37
    v_cvt_pk_bf16_f32 v29, v38, v39
    v_cvt_pk_bf16_f32 v30, v40, v41
    v_cvt_pk_bf16_f32 v31, v42, v43
    s_mov_b64 exec, s[24:25]
    s_cbranch_scc1 L_sB3
    global_store_dwordx4 v2, v[28:31], s[10:11]
    s_branch L_sC3
L_sB3:
    global_store_dwordx4 v2, v[28:31], s[10:11] sc0 sc1
L_sC3:
    s_mov_b64 exec, s[22:23]
    s_cbranch_execz L_end
    s_waitcnt vmcnt(4)
    v_lshlrev_b32 v36, 16, v48
    v_and_b32 v37, s16, v48
    v_lshlrev_b32 v38, 16, v49
    v_and_b32 v39, s16, v49
    v_lshlrev_b32 v40, 16, v50
    v_and_b32 v41, s16, v50
    v_lshlrev_b32 v42, 16, v51
    v_and_b32 v43, s16, v51
    v_pk_mul_f32 v[36:37], v[36:37], s[18:19]
    v_pk_mul_f32 v[38:39], v[38:39], s[18:19]
    v_pk_mul_f32 v[40:41], v[40:41], s[18:19]
    v_pk_mul_f32 v[42:43], v[42:43], s[18:19]
    v_cvt_pk_bf16_f32 v48, v36, v37
    v_cvt_pk_bf16_f32 v49, v38, v39
    v_cvt_pk_bf16_f32 v50, v40, v41
    v_cvt_pk_bf16_f32 v51, v42, v43
    v_lshlrev_b32 v36, 16, v48
    v_and_b32 v37, s16, v48
    v_lshlrev_b32 v38, 16, v49
    v_and_b32 v39, s16, v49
    v_lshlrev_b32 v40, 16, v50
    v_and_b32 v41, s16, v50
    v_lshlrev_b32 v42, 16, v51
    v_and_b32 v43, s16, v51
    s_waitcnt vmcnt(4)
    v_lshlrev_b32 v48, 16, v44
    v_and_b32 v49, s16, v44
    v_lshlrev_b32 v50, 16, v45
    v_and_b32 v51, s16, v45
    v_pk_add_f32 v[36:37], v[48:49], v[36:37] neg_lo:[0,1] neg_hi:[0,1]
    v_pk_add_f32 v[38:39], v[50:51], v[38:39] neg_lo:[0,1] neg_hi:[0,1]
    v_lshlrev_b32 v48, 16, v46
    v_and_b32 v49, s16, v46
    v_lshlrev_b32 v50, 16, v47
    v_and_b32 v51, s16, v47
    v_pk_add_f32 v[40:41], v[48:49], v[40:41] neg_lo:[0,1] neg_hi:[0,1]
    v_pk_add_f32 v[42:43], v[50:51], v[42:43] neg_lo:[0,1] neg_hi:[0,1]
    v_cvt_pk_bf16_f32 v44, v36, v37
    v_cvt_pk_bf16_f32 v45, v38, v39
    v_cvt_pk_bf16_f32 v46, v40, v41
    v_cvt_pk_bf16_f32 v47, v42, v43
    s_cbranch_scc1 L_sB4
    global_store_dwordx4 v3, v[44:47], s[10:11]
    s_branch L_sC4
L_sB4:
    global_store_dwordx4 v3, v[44:47], s[10:11] sc0 sc1
L_sC4:
L_end:
    s_endpgm
.section .rodata,"a"
.p2align 6
.amdhsa_kernel standalone__consistency_rf_step__diffusion_kernel
  .amdhsa_next_free_vgpr 52
  .amdhsa_next_free_sgpr 32
  .amdhsa_accum_offset 52
  .amdhsa_group_segment_fixed_size 0
  .amdhsa_kernarg_size 48
  .amdhsa_user_sgpr_count 2
  .amdhsa_user_sgpr_kernarg_segment_ptr 1
  .amdhsa_system_sgpr_workgroup_id_x 1
  .amdhsa_float_denorm_mode_32 3
  .amdhsa_float_denorm_mode_16_64 3
.end_amdhsa_kernel
```
